```python
import torch

def _softmax(x, axis=-1):
    return torch.softmax(x, dim=axis)
def _gelu(x):
    return torch.nn.functional.gelu(x, approximate="tanh")
def _silu(x):
    return torch.nn.functional.silu(x)
def _sigmoid(x):
    return torch.sigmoid(x)
def _layernorm(x, axis=-1, eps=1e-5):
    m = x.mean(dim=axis, keepdim=True)
    v = x.var(dim=axis, keepdim=True, unbiased=False)
    return (x - m) / torch.sqrt(v + eps)
def _scatter_add(tgt, idx, src, axis=0):
    return tgt.clone().index_add_(axis, idx, src)
def _segment_sum(src, seg, n):
    out = torch.zeros((n,) + src.shape[1:], dtype=src.dtype)
    return out.index_add_(0, seg, src)
def _pad(x, pw):
    flat = tuple(v for pair in reversed(pw) for v in pair)
    return torch.nn.functional.pad(x, flat)

kernel_name = 'standalone__fused_bias_dropout_add__prompt'

def setup_inputs():

    _w = (lambda a: (lambda t: t.to(torch.bfloat16) if t.is_floating_point() else t)(torch.as_tensor(a)))
    B, S, D = 2, 2048, 1024
    keep = 0.9
    mask = (torch.rand(B, S, D) < keep).to(float)
    return {
        "x": _w((lambda *s: torch.randn(*s, dtype=torch.bfloat16) * 0.05)(B, S, D)),
        "bias": _w((lambda *s: torch.randn(*s, dtype=torch.bfloat16) * 0.05)(D)),
        "mask": _w(mask),
        "residual": _w((lambda *s: torch.randn(*s, dtype=torch.bfloat16) * 0.05)(B, S, D)),
    }

def reference(x, bias, mask, residual):
    keep = 0.9
    return residual + (x + bias) * mask * (1.0 / keep)
```

```asm
; @launch grid=(256,1,1) block=(256,1,1) lds=0
.amdgcn_target "amdgcn-amd-amdhsa--gfx950"
.text
.globl standalone__fused_bias_dropout_add__prompt_kernel
.p2align 8
.type standalone__fused_bias_dropout_add__prompt_kernel,@function
standalone__fused_bias_dropout_add__prompt_kernel:
    s_load_dwordx8 s[4:11], s[0:1], 0
    s_load_dwordx2 s[12:13], s[0:1], 32
    s_lshl_b32 s3, s2, 15
    v_lshl_add_u32 v1, v0, 4, s3
    s_cmpk_ge_u32 s2, 256
    s_cbranch_scc1 L_done
    v_and_b32 v2, 0x7ff, v1
    s_waitcnt lgkmcnt(0)
    global_load_dwordx4 v[40:43], v1, s[4:5] nt
    global_load_dwordx4 v[44:47], v1, s[8:9] nt
    global_load_dwordx4 v[48:51], v1, s[10:11] nt
    global_load_dwordx4 v[12:15], v2, s[6:7]
    v_add_u32 v3, 0x1000, v1
    global_load_dwordx4 v[52:55], v3, s[4:5] nt
    global_load_dwordx4 v[56:59], v3, s[8:9] nt
    global_load_dwordx4 v[60:63], v3, s[10:11] nt
    v_add_u32 v4, 0x2000, v1
    global_load_dwordx4 v[64:67], v4, s[4:5] nt
    global_load_dwordx4 v[68:71], v4, s[8:9] nt
    global_load_dwordx4 v[72:75], v4, s[10:11] nt
    v_add_u32 v5, 0x3000, v1
    global_load_dwordx4 v[76:79], v5, s[4:5] nt
    global_load_dwordx4 v[80:83], v5, s[8:9] nt
    global_load_dwordx4 v[84:87], v5, s[10:11] nt
    s_mov_b32 s14, 0x3f8e38e4
    s_mov_b32 s15, 0x3f8e38e4
    s_mov_b32 s16, 0xffff0000
    v_add_u32 v6, 0x4000, v1
    v_add_u32 v7, 0x5000, v1
    v_add_u32 v8, 0x6000, v1
    v_add_u32 v9, 0x7000, v1
    s_waitcnt vmcnt(9)
    v_lshlrev_b32 v16, 16, v12
    v_and_b32 v17, s16, v12
    v_lshlrev_b32 v18, 16, v13
    v_and_b32 v19, s16, v13
    v_lshlrev_b32 v20, 16, v14
    v_and_b32 v21, s16, v14
    v_lshlrev_b32 v22, 16, v15
    v_and_b32 v23, s16, v15
    v_lshlrev_b32 v24, 16, v40
    v_and_b32 v25, s16, v40
    v_lshlrev_b32 v26, 16, v41
    v_and_b32 v27, s16, v41
    v_lshlrev_b32 v28, 16, v42
    v_and_b32 v29, s16, v42
    v_lshlrev_b32 v30, 16, v43
    v_and_b32 v31, s16, v43
    v_pk_add_f32 v[24:25], v[24:25], v[16:17]
    v_pk_add_f32 v[26:27], v[26:27], v[18:19]
    v_pk_add_f32 v[28:29], v[28:29], v[20:21]
    v_pk_add_f32 v[30:31], v[30:31], v[22:23]
    v_cvt_pk_bf16_f32 v24, 0, v24
    v_cvt_pk_bf16_f32 v25, 0, v25
    v_cvt_pk_bf16_f32 v26, 0, v26
    v_cvt_pk_bf16_f32 v27, 0, v27
    v_cvt_pk_bf16_f32 v28, 0, v28
    v_cvt_pk_bf16_f32 v29, 0, v29
    v_cvt_pk_bf16_f32 v30, 0, v30
    v_cvt_pk_bf16_f32 v31, 0, v31
    v_lshlrev_b32 v32, 16, v44
    v_and_b32 v33, s16, v44
    v_lshlrev_b32 v34, 16, v45
    v_and_b32 v35, s16, v45
    v_lshlrev_b32 v36, 16, v46
    v_and_b32 v37, s16, v46
    v_lshlrev_b32 v38, 16, v47
    v_and_b32 v39, s16, v47
    v_pk_mul_f32 v[24:25], v[24:25], v[32:33]
    v_pk_mul_f32 v[26:27], v[26:27], v[34:35]
    v_pk_mul_f32 v[28:29], v[28:29], v[36:37]
    v_pk_mul_f32 v[30:31], v[30:31], v[38:39]
    v_pk_mul_f32 v[24:25], v[24:25], s[14:15]
    v_pk_mul_f32 v[26:27], v[26:27], s[14:15]
    v_pk_mul_f32 v[28:29], v[28:29], s[14:15]
    v_pk_mul_f32 v[30:31], v[30:31], s[14:15]
    v_cvt_pk_bf16_f32 v24, 0, v24
    v_cvt_pk_bf16_f32 v25, 0, v25
    v_cvt_pk_bf16_f32 v26, 0, v26
    v_cvt_pk_bf16_f32 v27, 0, v27
    v_cvt_pk_bf16_f32 v28, 0, v28
    v_cvt_pk_bf16_f32 v29, 0, v29
    v_cvt_pk_bf16_f32 v30, 0, v30
    v_cvt_pk_bf16_f32 v31, 0, v31
    v_lshlrev_b32 v32, 16, v48
    v_and_b32 v33, s16, v48
    v_lshlrev_b32 v34, 16, v49
    v_and_b32 v35, s16, v49
    v_lshlrev_b32 v36, 16, v50
    v_and_b32 v37, s16, v50
    v_lshlrev_b32 v38, 16, v51
    v_and_b32 v39, s16, v51
    v_pk_add_f32 v[24:25], v[24:25], v[32:33]
    v_pk_add_f32 v[26:27], v[26:27], v[34:35]
    v_pk_add_f32 v[28:29], v[28:29], v[36:37]
    v_pk_add_f32 v[30:31], v[30:31], v[38:39]
    v_cvt_pk_bf16_f32 v48, v24, v25
    v_cvt_pk_bf16_f32 v49, v26, v27
    v_cvt_pk_bf16_f32 v50, v28, v29
    v_cvt_pk_bf16_f32 v51, v30, v31
    global_store_dwordx4 v1, v[48:51], s[12:13]
    global_load_dwordx4 v[40:43], v6, s[4:5] nt
    global_load_dwordx4 v[44:47], v6, s[8:9] nt
    global_load_dwordx4 v[48:51], v6, s[10:11] nt
    s_waitcnt vmcnt(12)
    v_lshlrev_b32 v24, 16, v52
    v_and_b32 v25, s16, v52
    v_lshlrev_b32 v26, 16, v53
    v_and_b32 v27, s16, v53
    v_lshlrev_b32 v28, 16, v54
    v_and_b32 v29, s16, v54
    v_lshlrev_b32 v30, 16, v55
    v_and_b32 v31, s16, v55
    v_pk_add_f32 v[24:25], v[24:25], v[16:17]
    v_pk_add_f32 v[26:27], v[26:27], v[18:19]
    v_pk_add_f32 v[28:29], v[28:29], v[20:21]
    v_pk_add_f32 v[30:31], v[30:31], v[22:23]
    v_cvt_pk_bf16_f32 v24, 0, v24
    v_cvt_pk_bf16_f32 v25, 0, v25
    v_cvt_pk_bf16_f32 v26, 0, v26
    v_cvt_pk_bf16_f32 v27, 0, v27
    v_cvt_pk_bf16_f32 v28, 0, v28
    v_cvt_pk_bf16_f32 v29, 0, v29
    v_cvt_pk_bf16_f32 v30, 0, v30
    v_cvt_pk_bf16_f32 v31, 0, v31
    s_waitcnt vmcnt(11)
    v_lshlrev_b32 v32, 16, v56
    v_and_b32 v33, s16, v56
    v_lshlrev_b32 v34, 16, v57
    v_and_b32 v35, s16, v57
    v_lshlrev_b32 v36, 16, v58
    v_and_b32 v37, s16, v58
    v_lshlrev_b32 v38, 16, v59
    v_and_b32 v39, s16, v59
    v_pk_mul_f32 v[24:25], v[24:25], v[32:33]
    v_pk_mul_f32 v[26:27], v[26:27], v[34:35]
    v_pk_mul_f32 v[28:29], v[28:29], v[36:37]
    v_pk_mul_f32 v[30:31], v[30:31], v[38:39]
    v_pk_mul_f32 v[24:25], v[24:25], s[14:15]
    v_pk_mul_f32 v[26:27], v[26:27], s[14:15]
    v_pk_mul_f32 v[28:29], v[28:29], s[14:15]
    v_pk_mul_f32 v[30:31], v[30:31], s[14:15]
    v_cvt_pk_bf16_f32 v24, 0, v24
    v_cvt_pk_bf16_f32 v25, 0, v25
    v_cvt_pk_bf16_f32 v26, 0, v26
    v_cvt_pk_bf16_f32 v27, 0, v27
    v_cvt_pk_bf16_f32 v28, 0, v28
    v_cvt_pk_bf16_f32 v29, 0, v29
    v_cvt_pk_bf16_f32 v30, 0, v30
    v_cvt_pk_bf16_f32 v31, 0, v31
    s_waitcnt vmcnt(10)
    v_lshlrev_b32 v32, 16, v60
    v_and_b32 v33, s16, v60
    v_lshlrev_b32 v34, 16, v61
    v_and_b32 v35, s16, v61
    v_lshlrev_b32 v36, 16, v62
    v_and_b32 v37, s16, v62
    v_lshlrev_b32 v38, 16, v63
    v_and_b32 v39, s16, v63
    v_pk_add_f32 v[24:25], v[24:25], v[32:33]
    v_pk_add_f32 v[26:27], v[26:27], v[34:35]
    v_pk_add_f32 v[28:29], v[28:29], v[36:37]
    v_pk_add_f32 v[30:31], v[30:31], v[38:39]
    v_cvt_pk_bf16_f32 v60, v24, v25
    v_cvt_pk_bf16_f32 v61, v26, v27
    v_cvt_pk_bf16_f32 v62, v28, v29
    v_cvt_pk_bf16_f32 v63, v30, v31
    global_store_dwordx4 v3, v[60:63], s[12:13]
    global_load_dwordx4 v[52:55], v7, s[4:5] nt
    global_load_dwordx4 v[56:59], v7, s[8:9] nt
    global_load_dwordx4 v[60:63], v7, s[10:11] nt
    s_waitcnt vmcnt(13)
    v_lshlrev_b32 v24, 16, v64
    v_and_b32 v25, s16, v64
    v_lshlrev_b32 v26, 16, v65
    v_and_b32 v27, s16, v65
    v_lshlrev_b32 v28, 16, v66
    v_and_b32 v29, s16, v66
    v_lshlrev_b32 v30, 16, v67
    v_and_b32 v31, s16, v67
    v_pk_add_f32 v[24:25], v[24:25], v[16:17]
    v_pk_add_f32 v[26:27], v[26:27], v[18:19]
    v_pk_add_f32 v[28:29], v[28:29], v[20:21]
    v_pk_add_f32 v[30:31], v[30:31], v[22:23]
    v_cvt_pk_bf16_f32 v24, 0, v24
    v_cvt_pk_bf16_f32 v25, 0, v25
    v_cvt_pk_bf16_f32 v26, 0, v26
    v_cvt_pk_bf16_f32 v27, 0, v27
    v_cvt_pk_bf16_f32 v28, 0, v28
    v_cvt_pk_bf16_f32 v29, 0, v29
    v_cvt_pk_bf16_f32 v30, 0, v30
    v_cvt_pk_bf16_f32 v31, 0, v31
    s_waitcnt vmcnt(12)
    v_lshlrev_b32 v32, 16, v68
    v_and_b32 v33, s16, v68
    v_lshlrev_b32 v34, 16, v69
    v_and_b32 v35, s16, v69
    v_lshlrev_b32 v36, 16, v70
    v_and_b32 v37, s16, v70
    v_lshlrev_b32 v38, 16, v71
    v_and_b32 v39, s16, v71
    v_pk_mul_f32 v[24:25], v[24:25], v[32:33]
    v_pk_mul_f32 v[26:27], v[26:27], v[34:35]
    v_pk_mul_f32 v[28:29], v[28:29], v[36:37]
    v_pk_mul_f32 v[30:31], v[30:31], v[38:39]
    v_pk_mul_f32 v[24:25], v[24:25], s[14:15]
    v_pk_mul_f32 v[26:27], v[26:27], s[14:15]
    v_pk_mul_f32 v[28:29], v[28:29], s[14:15]
    v_pk_mul_f32 v[30:31], v[30:31], s[14:15]
    v_cvt_pk_bf16_f32 v24, 0, v24
    v_cvt_pk_bf16_f32 v25, 0, v25
    v_cvt_pk_bf16_f32 v26, 0, v26
    v_cvt_pk_bf16_f32 v27, 0, v27
    v_cvt_pk_bf16_f32 v28, 0, v28
    v_cvt_pk_bf16_f32 v29, 0, v29
    v_cvt_pk_bf16_f32 v30, 0, v30
    v_cvt_pk_bf16_f32 v31, 0, v31
    s_waitcnt vmcnt(11)
    v_lshlrev_b32 v32, 16, v72
    v_and_b32 v33, s16, v72
    v_lshlrev_b32 v34, 16, v73
    v_and_b32 v35, s16, v73
    v_lshlrev_b32 v36, 16, v74
    v_and_b32 v37, s16, v74
    v_lshlrev_b32 v38, 16, v75
    v_and_b32 v39, s16, v75
    v_pk_add_f32 v[24:25], v[24:25], v[32:33]
    v_pk_add_f32 v[26:27], v[26:27], v[34:35]
    v_pk_add_f32 v[28:29], v[28:29], v[36:37]
    v_pk_add_f32 v[30:31], v[30:31], v[38:39]
    v_cvt_pk_bf16_f32 v72, v24, v25
    v_cvt_pk_bf16_f32 v73, v26, v27
    v_cvt_pk_bf16_f32 v74, v28, v29
    v_cvt_pk_bf16_f32 v75, v30, v31
    global_store_dwordx4 v4, v[72:75], s[12:13]
    global_load_dwordx4 v[64:67], v8, s[4:5] nt
    global_load_dwordx4 v[68:71], v8, s[8:9] nt
    global_load_dwordx4 v[72:75], v8, s[10:11] nt
    s_waitcnt vmcnt(14)
    v_lshlrev_b32 v24, 16, v76
    v_and_b32 v25, s16, v76
    v_lshlrev_b32 v26, 16, v77
    v_and_b32 v27, s16, v77
    v_lshlrev_b32 v28, 16, v78
    v_and_b32 v29, s16, v78
    v_lshlrev_b32 v30, 16, v79
    v_and_b32 v31, s16, v79
    v_pk_add_f32 v[24:25], v[24:25], v[16:17]
    v_pk_add_f32 v[26:27], v[26:27], v[18:19]
    v_pk_add_f32 v[28:29], v[28:29], v[20:21]
    v_pk_add_f32 v[30:31], v[30:31], v[22:23]
    v_cvt_pk_bf16_f32 v24, 0, v24
    v_cvt_pk_bf16_f32 v25, 0, v25
    v_cvt_pk_bf16_f32 v26, 0, v26
    v_cvt_pk_bf16_f32 v27, 0, v27
    v_cvt_pk_bf16_f32 v28, 0, v28
    v_cvt_pk_bf16_f32 v29, 0, v29
    v_cvt_pk_bf16_f32 v30, 0, v30
    v_cvt_pk_bf16_f32 v31, 0, v31
    s_waitcnt vmcnt(13)
    v_lshlrev_b32 v32, 16, v80
    v_and_b32 v33, s16, v80
    v_lshlrev_b32 v34, 16, v81
    v_and_b32 v35, s16, v81
    v_lshlrev_b32 v36, 16, v82
    v_and_b32 v37, s16, v82
    v_lshlrev_b32 v38, 16, v83
    v_and_b32 v39, s16, v83
    v_pk_mul_f32 v[24:25], v[24:25], v[32:33]
    v_pk_mul_f32 v[26:27], v[26:27], v[34:35]
    v_pk_mul_f32 v[28:29], v[28:29], v[36:37]
    v_pk_mul_f32 v[30:31], v[30:31], v[38:39]
    v_pk_mul_f32 v[24:25], v[24:25], s[14:15]
    v_pk_mul_f32 v[26:27], v[26:27], s[14:15]
    v_pk_mul_f32 v[28:29], v[28:29], s[14:15]
    v_pk_mul_f32 v[30:31], v[30:31], s[14:15]
    v_cvt_pk_bf16_f32 v24, 0, v24
    v_cvt_pk_bf16_f32 v25, 0, v25
    v_cvt_pk_bf16_f32 v26, 0, v26
    v_cvt_pk_bf16_f32 v27, 0, v27
    v_cvt_pk_bf16_f32 v28, 0, v28
    v_cvt_pk_bf16_f32 v29, 0, v29
    v_cvt_pk_bf16_f32 v30, 0, v30
    v_cvt_pk_bf16_f32 v31, 0, v31
    s_waitcnt vmcnt(12)
    v_lshlrev_b32 v32, 16, v84
    v_and_b32 v33, s16, v84
    v_lshlrev_b32 v34, 16, v85
    v_and_b32 v35, s16, v85
    v_lshlrev_b32 v36, 16, v86
    v_and_b32 v37, s16, v86
    v_lshlrev_b32 v38, 16, v87
    v_and_b32 v39, s16, v87
    v_pk_add_f32 v[24:25], v[24:25], v[32:33]
    v_pk_add_f32 v[26:27], v[26:27], v[34:35]
    v_pk_add_f32 v[28:29], v[28:29], v[36:37]
    v_pk_add_f32 v[30:31], v[30:31], v[38:39]
    v_cvt_pk_bf16_f32 v84, v24, v25
    v_cvt_pk_bf16_f32 v85, v26, v27
    v_cvt_pk_bf16_f32 v86, v28, v29
    v_cvt_pk_bf16_f32 v87, v30, v31
    global_store_dwordx4 v5, v[84:87], s[12:13]
    global_load_dwordx4 v[76:79], v9, s[4:5] nt
    global_load_dwordx4 v[80:83], v9, s[8:9] nt
    global_load_dwordx4 v[84:87], v9, s[10:11] nt
    s_waitcnt vmcnt(14)
    v_lshlrev_b32 v24, 16, v40
    v_and_b32 v25, s16, v40
    v_lshlrev_b32 v26, 16, v41
    v_and_b32 v27, s16, v41
    v_lshlrev_b32 v28, 16, v42
    v_and_b32 v29, s16, v42
    v_lshlrev_b32 v30, 16, v43
    v_and_b32 v31, s16, v43
    v_pk_add_f32 v[24:25], v[24:25], v[16:17]
    v_pk_add_f32 v[26:27], v[26:27], v[18:19]
    v_pk_add_f32 v[28:29], v[28:29], v[20:21]
    v_pk_add_f32 v[30:31], v[30:31], v[22:23]
    v_cvt_pk_bf16_f32 v24, 0, v24
    v_cvt_pk_bf16_f32 v25, 0, v25
    v_cvt_pk_bf16_f32 v26, 0, v26
    v_cvt_pk_bf16_f32 v27, 0, v27
    v_cvt_pk_bf16_f32 v28, 0, v28
    v_cvt_pk_bf16_f32 v29, 0, v29
    v_cvt_pk_bf16_f32 v30, 0, v30
    v_cvt_pk_bf16_f32 v31, 0, v31
    s_waitcnt vmcnt(13)
    v_lshlrev_b32 v32, 16, v44
    v_and_b32 v33, s16, v44
    v_lshlrev_b32 v34, 16, v45
    v_and_b32 v35, s16, v45
    v_lshlrev_b32 v36, 16, v46
    v_and_b32 v37, s16, v46
    v_lshlrev_b32 v38, 16, v47
    v_and_b32 v39, s16, v47
    v_pk_mul_f32 v[24:25], v[24:25], v[32:33]
    v_pk_mul_f32 v[26:27], v[26:27], v[34:35]
    v_pk_mul_f32 v[28:29], v[28:29], v[36:37]
    v_pk_mul_f32 v[30:31], v[30:31], v[38:39]
    v_pk_mul_f32 v[24:25], v[24:25], s[14:15]
    v_pk_mul_f32 v[26:27], v[26:27], s[14:15]
    v_pk_mul_f32 v[28:29], v[28:29], s[14:15]
    v_pk_mul_f32 v[30:31], v[30:31], s[14:15]
    v_cvt_pk_bf16_f32 v24, 0, v24
    v_cvt_pk_bf16_f32 v25, 0, v25
    v_cvt_pk_bf16_f32 v26, 0, v26
    v_cvt_pk_bf16_f32 v27, 0, v27
    v_cvt_pk_bf16_f32 v28, 0, v28
    v_cvt_pk_bf16_f32 v29, 0, v29
    v_cvt_pk_bf16_f32 v30, 0, v30
    v_cvt_pk_bf16_f32 v31, 0, v31
    s_waitcnt vmcnt(12)
    v_lshlrev_b32 v32, 16, v48
    v_and_b32 v33, s16, v48
    v_lshlrev_b32 v34, 16, v49
    v_and_b32 v35, s16, v49
    v_lshlrev_b32 v36, 16, v50
    v_and_b32 v37, s16, v50
    v_lshlrev_b32 v38, 16, v51
    v_and_b32 v39, s16, v51
    v_pk_add_f32 v[24:25], v[24:25], v[32:33]
    v_pk_add_f32 v[26:27], v[26:27], v[34:35]
    v_pk_add_f32 v[28:29], v[28:29], v[36:37]
    v_pk_add_f32 v[30:31], v[30:31], v[38:39]
    v_cvt_pk_bf16_f32 v48, v24, v25
    v_cvt_pk_bf16_f32 v49, v26, v27
    v_cvt_pk_bf16_f32 v50, v28, v29
    v_cvt_pk_bf16_f32 v51, v30, v31
    global_store_dwordx4 v6, v[48:51], s[12:13]
    s_waitcnt vmcnt(11)
    v_lshlrev_b32 v24, 16, v52
    v_and_b32 v25, s16, v52
    v_lshlrev_b32 v26, 16, v53
    v_and_b32 v27, s16, v53
    v_lshlrev_b32 v28, 16, v54
    v_and_b32 v29, s16, v54
    v_lshlrev_b32 v30, 16, v55
    v_and_b32 v31, s16, v55
    v_pk_add_f32 v[24:25], v[24:25], v[16:17]
    v_pk_add_f32 v[26:27], v[26:27], v[18:19]
    v_pk_add_f32 v[28:29], v[28:29], v[20:21]
    v_pk_add_f32 v[30:31], v[30:31], v[22:23]
    v_cvt_pk_bf16_f32 v24, 0, v24
    v_cvt_pk_bf16_f32 v25, 0, v25
    v_cvt_pk_bf16_f32 v26, 0, v26
    v_cvt_pk_bf16_f32 v27, 0, v27
    v_cvt_pk_bf16_f32 v28, 0, v28
    v_cvt_pk_bf16_f32 v29, 0, v29
    v_cvt_pk_bf16_f32 v30, 0, v30
    v_cvt_pk_bf16_f32 v31, 0, v31
    s_waitcnt vmcnt(10)
    v_lshlrev_b32 v32, 16, v56
    v_and_b32 v33, s16, v56
    v_lshlrev_b32 v34, 16, v57
    v_and_b32 v35, s16, v57
    v_lshlrev_b32 v36, 16, v58
    v_and_b32 v37, s16, v58
    v_lshlrev_b32 v38, 16, v59
    v_and_b32 v39, s16, v59
    v_pk_mul_f32 v[24:25], v[24:25], v[32:33]
    v_pk_mul_f32 v[26:27], v[26:27], v[34:35]
    v_pk_mul_f32 v[28:29], v[28:29], v[36:37]
    v_pk_mul_f32 v[30:31], v[30:31], v[38:39]
    v_pk_mul_f32 v[24:25], v[24:25], s[14:15]
    v_pk_mul_f32 v[26:27], v[26:27], s[14:15]
    v_pk_mul_f32 v[28:29], v[28:29], s[14:15]
    v_pk_mul_f32 v[30:31], v[30:31], s[14:15]
    v_cvt_pk_bf16_f32 v24, 0, v24
    v_cvt_pk_bf16_f32 v25, 0, v25
    v_cvt_pk_bf16_f32 v26, 0, v26
    v_cvt_pk_bf16_f32 v27, 0, v27
    v_cvt_pk_bf16_f32 v28, 0, v28
    v_cvt_pk_bf16_f32 v29, 0, v29
    v_cvt_pk_bf16_f32 v30, 0, v30
    v_cvt_pk_bf16_f32 v31, 0, v31
    s_waitcnt vmcnt(9)
    v_lshlrev_b32 v32, 16, v60
    v_and_b32 v33, s16, v60
    v_lshlrev_b32 v34, 16, v61
    v_and_b32 v35, s16, v61
    v_lshlrev_b32 v36, 16, v62
    v_and_b32 v37, s16, v62
    v_lshlrev_b32 v38, 16, v63
    v_and_b32 v39, s16, v63
    v_pk_add_f32 v[24:25], v[24:25], v[32:33]
    v_pk_add_f32 v[26:27], v[26:27], v[34:35]
    v_pk_add_f32 v[28:29], v[28:29], v[36:37]
    v_pk_add_f32 v[30:31], v[30:31], v[38:39]
    v_cvt_pk_bf16_f32 v60, v24, v25
    v_cvt_pk_bf16_f32 v61, v26, v27
    v_cvt_pk_bf16_f32 v62, v28, v29
    v_cvt_pk_bf16_f32 v63, v30, v31
    global_store_dwordx4 v7, v[60:63], s[12:13]
    s_waitcnt vmcnt(8)
    v_lshlrev_b32 v24, 16, v64
    v_and_b32 v25, s16, v64
    v_lshlrev_b32 v26, 16, v65
    v_and_b32 v27, s16, v65
    v_lshlrev_b32 v28, 16, v66
    v_and_b32 v29, s16, v66
    v_lshlrev_b32 v30, 16, v67
    v_and_b32 v31, s16, v67
    v_pk_add_f32 v[24:25], v[24:25], v[16:17]
    v_pk_add_f32 v[26:27], v[26:27], v[18:19]
    v_pk_add_f32 v[28:29], v[28:29], v[20:21]
    v_pk_add_f32 v[30:31], v[30:31], v[22:23]
    v_cvt_pk_bf16_f32 v24, 0, v24
    v_cvt_pk_bf16_f32 v25, 0, v25
    v_cvt_pk_bf16_f32 v26, 0, v26
    v_cvt_pk_bf16_f32 v27, 0, v27
    v_cvt_pk_bf16_f32 v28, 0, v28
    v_cvt_pk_bf16_f32 v29, 0, v29
    v_cvt_pk_bf16_f32 v30, 0, v30
    v_cvt_pk_bf16_f32 v31, 0, v31
    s_waitcnt vmcnt(7)
    v_lshlrev_b32 v32, 16, v68
    v_and_b32 v33, s16, v68
    v_lshlrev_b32 v34, 16, v69
    v_and_b32 v35, s16, v69
    v_lshlrev_b32 v36, 16, v70
    v_and_b32 v37, s16, v70
    v_lshlrev_b32 v38, 16, v71
    v_and_b32 v39, s16, v71
    v_pk_mul_f32 v[24:25], v[24:25], v[32:33]
    v_pk_mul_f32 v[26:27], v[26:27], v[34:35]
    v_pk_mul_f32 v[28:29], v[28:29], v[36:37]
    v_pk_mul_f32 v[30:31], v[30:31], v[38:39]
    v_pk_mul_f32 v[24:25], v[24:25], s[14:15]
    v_pk_mul_f32 v[26:27], v[26:27], s[14:15]
    v_pk_mul_f32 v[28:29], v[28:29], s[14:15]
    v_pk_mul_f32 v[30:31], v[30:31], s[14:15]
    v_cvt_pk_bf16_f32 v24, 0, v24
    v_cvt_pk_bf16_f32 v25, 0, v25
    v_cvt_pk_bf16_f32 v26, 0, v26
    v_cvt_pk_bf16_f32 v27, 0, v27
    v_cvt_pk_bf16_f32 v28, 0, v28
    v_cvt_pk_bf16_f32 v29, 0, v29
    v_cvt_pk_bf16_f32 v30, 0, v30
    v_cvt_pk_bf16_f32 v31, 0, v31
    s_waitcnt vmcnt(6)
    v_lshlrev_b32 v32, 16, v72
    v_and_b32 v33, s16, v72
    v_lshlrev_b32 v34, 16, v73
    v_and_b32 v35, s16, v73
    v_lshlrev_b32 v36, 16, v74
    v_and_b32 v37, s16, v74
    v_lshlrev_b32 v38, 16, v75
    v_and_b32 v39, s16, v75
    v_pk_add_f32 v[24:25], v[24:25], v[32:33]
    v_pk_add_f32 v[26:27], v[26:27], v[34:35]
    v_pk_add_f32 v[28:29], v[28:29], v[36:37]
    v_pk_add_f32 v[30:31], v[30:31], v[38:39]
    v_cvt_pk_bf16_f32 v72, v24, v25
    v_cvt_pk_bf16_f32 v73, v26, v27
    v_cvt_pk_bf16_f32 v74, v28, v29
    v_cvt_pk_bf16_f32 v75, v30, v31
    global_store_dwordx4 v8, v[72:75], s[12:13]
    s_waitcnt vmcnt(5)
    v_lshlrev_b32 v24, 16, v76
    v_and_b32 v25, s16, v76
    v_lshlrev_b32 v26, 16, v77
    v_and_b32 v27, s16, v77
    v_lshlrev_b32 v28, 16, v78
    v_and_b32 v29, s16, v78
    v_lshlrev_b32 v30, 16, v79
    v_and_b32 v31, s16, v79
    v_pk_add_f32 v[24:25], v[24:25], v[16:17]
    v_pk_add_f32 v[26:27], v[26:27], v[18:19]
    v_pk_add_f32 v[28:29], v[28:29], v[20:21]
    v_pk_add_f32 v[30:31], v[30:31], v[22:23]
    v_cvt_pk_bf16_f32 v24, 0, v24
    v_cvt_pk_bf16_f32 v25, 0, v25
    v_cvt_pk_bf16_f32 v26, 0, v26
    v_cvt_pk_bf16_f32 v27, 0, v27
    v_cvt_pk_bf16_f32 v28, 0, v28
    v_cvt_pk_bf16_f32 v29, 0, v29
    v_cvt_pk_bf16_f32 v30, 0, v30
    v_cvt_pk_bf16_f32 v31, 0, v31
    s_waitcnt vmcnt(4)
    v_lshlrev_b32 v32, 16, v80
    v_and_b32 v33, s16, v80
    v_lshlrev_b32 v34, 16, v81
    v_and_b32 v35, s16, v81
    v_lshlrev_b32 v36, 16, v82
    v_and_b32 v37, s16, v82
    v_lshlrev_b32 v38, 16, v83
    v_and_b32 v39, s16, v83
    v_pk_mul_f32 v[24:25], v[24:25], v[32:33]
    v_pk_mul_f32 v[26:27], v[26:27], v[34:35]
    v_pk_mul_f32 v[28:29], v[28:29], v[36:37]
    v_pk_mul_f32 v[30:31], v[30:31], v[38:39]
    v_pk_mul_f32 v[24:25], v[24:25], s[14:15]
    v_pk_mul_f32 v[26:27], v[26:27], s[14:15]
    v_pk_mul_f32 v[28:29], v[28:29], s[14:15]
    v_pk_mul_f32 v[30:31], v[30:31], s[14:15]
    v_cvt_pk_bf16_f32 v24, 0, v24
    v_cvt_pk_bf16_f32 v25, 0, v25
    v_cvt_pk_bf16_f32 v26, 0, v26
    v_cvt_pk_bf16_f32 v27, 0, v27
    v_cvt_pk_bf16_f32 v28, 0, v28
    v_cvt_pk_bf16_f32 v29, 0, v29
    v_cvt_pk_bf16_f32 v30, 0, v30
    v_cvt_pk_bf16_f32 v31, 0, v31
    s_waitcnt vmcnt(3)
    v_lshlrev_b32 v32, 16, v84
    v_and_b32 v33, s16, v84
    v_lshlrev_b32 v34, 16, v85
    v_and_b32 v35, s16, v85
    v_lshlrev_b32 v36, 16, v86
    v_and_b32 v37, s16, v86
    v_lshlrev_b32 v38, 16, v87
    v_and_b32 v39, s16, v87
    v_pk_add_f32 v[24:25], v[24:25], v[32:33]
    v_pk_add_f32 v[26:27], v[26:27], v[34:35]
    v_pk_add_f32 v[28:29], v[28:29], v[36:37]
    v_pk_add_f32 v[30:31], v[30:31], v[38:39]
    v_cvt_pk_bf16_f32 v84, v24, v25
    v_cvt_pk_bf16_f32 v85, v26, v27
    v_cvt_pk_bf16_f32 v86, v28, v29
    v_cvt_pk_bf16_f32 v87, v30, v31
    global_store_dwordx4 v9, v[84:87], s[12:13]
L_done:
    s_endpgm
.section .rodata,"a"
.p2align 8
.amdhsa_kernel standalone__fused_bias_dropout_add__prompt_kernel
  .amdhsa_next_free_vgpr 88
  .amdhsa_next_free_sgpr 18
  .amdhsa_accum_offset 88
  .amdhsa_group_segment_fixed_size 0
  .amdhsa_kernarg_size 56
  .amdhsa_user_sgpr_count 2
  .amdhsa_user_sgpr_kernarg_segment_ptr 1
  .amdhsa_system_sgpr_workgroup_id_x 1
  .amdhsa_float_denorm_mode_32 3
.end_amdhsa_kernel
```
